```python
import torch

def _softmax(x, axis=-1):
    return torch.softmax(x, dim=axis)
def _gelu(x):
    return torch.nn.functional.gelu(x, approximate="tanh")
def _silu(x):
    return torch.nn.functional.silu(x)
def _sigmoid(x):
    return torch.sigmoid(x)
def _layernorm(x, axis=-1, eps=1e-5):
    m = x.mean(dim=axis, keepdim=True)
    v = x.var(dim=axis, keepdim=True, unbiased=False)
    return (x - m) / torch.sqrt(v + eps)
def _scatter_add(tgt, idx, src, axis=0):
    return tgt.clone().index_add_(axis, idx, src)
def _segment_sum(src, seg, n):
    out = torch.zeros((n,) + src.shape[1:], dtype=src.dtype)
    return out.index_add_(0, seg, src)
def _pad(x, pw):
    flat = tuple(v for pair in reversed(pw) for v in pair)
    return torch.nn.functional.pad(x, flat)

kernel_name = 'gather_scatter__kernel_systems_refs_featgraph__graph'

def setup_inputs():

    _w = (lambda a: (lambda t: t.to(torch.bfloat16) if t.is_floating_point() else t)(torch.as_tensor(a)))
    N, deg, D = 12500, 32, 128
    E = N * deg
    scale = D ** -0.5
    src = (lambda lo, hi, *s: torch.randint(lo, hi, s))(0, N, E).to(torch.int64)
    dst = (lambda lo, hi, *s: torch.randint(lo, hi, s))(0, N, E).to(torch.int64)
    return {
        "x": _w((lambda *s: torch.randn(*s, dtype=torch.bfloat16) * 0.8)(N, D)),
        "src": _w(src),
        "dst": _w(dst),
        "w_q": _w((lambda *s: torch.randn(*s, dtype=torch.bfloat16) * 0.8)(D, D) * scale),
        "w_v": _w((lambda *s: torch.randn(*s, dtype=torch.bfloat16) * 0.05)(D, D) * scale),
    }

def reference(x, src, dst, w_q, w_v):
    N, D = x.shape
    xs = x[src]
    xd = x[dst]
    q = xd @ w_q
    logits = torch.einsum('ed,ed->e', xs, q) * (float(D) ** -0.5)
    alpha = _sigmoid(logits)
    msg = alpha[:, None] * (xs @ w_v)
    return _segment_sum(msg, dst, N)
```

```asm
; @launch grid=(256,1,1) block=(1024,1,1) lds=156928
.amdgcn_target "amdgcn-amd-amdhsa--gfx950"
.text
.globl gather_scatter__kernel_systems_refs_featgraph__graph_kernel
.p2align 8
.type gather_scatter__kernel_systems_refs_featgraph__graph_kernel,@function
gather_scatter__kernel_systems_refs_featgraph__graph_kernel:
  s_cmp_ge_u32 s2, 256
  s_cbranch_scc1 K2_END
  s_load_dwordx2 s[20:21], s[0:1], 56
  s_load_dwordx2 s[60:61], s[0:1], 16
  s_load_dwordx2 s[56:57], s[0:1], 8
  s_load_dwordx2 s[4:5], s[0:1], 0
  s_load_dwordx2 s[8:9], s[0:1], 24
  s_load_dwordx2 s[12:13], s[0:1], 32
  s_load_dwordx2 s[16:17], s[0:1], 40
  s_mov_b32 s22, 9437184
  s_mov_b32 s23, 0x00020000
  s_mov_b32 s62, 1600000
  s_mov_b32 s63, 0x00020000
  s_mov_b32 s58, 1600000
  s_mov_b32 s59, 0x00020000
  s_mov_b32 s6, 3200000
  s_mov_b32 s7, 0x00020000
  s_mov_b32 s10, 32768
  s_mov_b32 s11, 0x00020000
  v_lshrrev_b32 v17, 6, v0
  s_mov_b32 s24, s2
  s_mul_i32 s3, s2, 6256
  v_readfirstlane_b32 s25, v17
  v_lshlrev_b32 v19, 3, v0
  v_add_u32 v19, s3, v19
  s_movk_i32 s55, 782
  s_cmp_eq_u32 s2, 255
  s_cselect_b32 s55, 590, s55
  v_mov_b32 v20, 0
  v_cmp_gt_u32 vcc, s55, v0
  s_and_saveexec_b64 s[50:51], vcc
  s_waitcnt lgkmcnt(0)
  s_cbranch_execz K1_NOEDGE0
  buffer_load_dwordx2 v[56:57], v19, s[60:63], 0 offen
  buffer_load_dwordx2 v[58:59], v19, s[56:59], 0 offen
K1_NOEDGE0:
  s_mov_b64 exec, s[50:51]
  buffer_load_dword v66, v20, s[20:23], 0 offen sc1
  v_and_b32 v21, 63, v0
  v_bfe_u32 v17, v0, 4, 2
  v_and_b32 v18, 15, v0
  v_lshlrev_b32 v1, 4, v18
  v_mov_b32 v68, 63
  v_mov_b32 v69, 63
  v_mov_b32 v70, 63
  v_mov_b32 v71, 63
  v_lshlrev_b32 v19, 4, v0
  ds_write_b128 v19, v[68:71] offset:46336
  s_cmp_eq_u32 s25, 12
  s_cbranch_scc0 K1_NOS2
  v_lshlrev_b32 v20, 4, v21
  v_add_u32 v20, 154880, v20
  ds_write_b128 v20, v[68:71]
K1_NOS2:
  v_mov_b32 v19, 0
  v_lshlrev_b32 v20, 2, v0
  s_cmp_ge_u32 s25, 6
  s_cbranch_scc1 K1_NOZ0
  v_add_u32 v20, 153344, v20
  ds_write_b32 v20, v19
  s_branch K1_NOZ1
K1_NOZ0:
  s_sub_u32 s3, s25, 8
  s_cmp_ge_u32 s3, 4
  s_cbranch_scc1 K1_NOZ2
  v_add_u32 v20, -2048, v20
  ds_write_b32 v20, v19
  s_branch K1_NOZ1
K1_NOZ2:
  s_cmp_lt_u32 s25, 12
  s_cbranch_scc1 K1_NOZ1
  v_add_u32 v20, 152832, v20
  ds_write_b32 v20, v19
K1_NOZ1:
  s_mov_b32 s26, 0
  s_mov_b32 s28, 0xaaaaaaaa
  s_mov_b32 s29, 0xaaaaaaaa
  s_movk_i32 s34, 196
  s_lshl_b32 s3, s25, 11
  s_add_u32 s3, s3, 62720
  v_lshl_add_u32 v2, v17, 9, s3
  v_add_u32 v2, v2, v1
  s_and_b32 s3, s2, 7
  s_lshl_b32 s3, s3, 5
  s_lshr_b32 s55, s2, 3
  s_add_u32 s3, s3, s55
  s_mov_b32 s31, s3
  v_lshrrev_b32 v19, 2, v0
  v_lshlrev_b32 v67, 14, v19
  v_and_b32 v19, 3, v0
  v_lshl_add_u32 v67, v19, 4, v67
  v_mov_b32 v20, 1
  s_waitcnt lgkmcnt(0)
  s_barrier
  v_bfe_u32 v17, v0, 4, 2
  v_and_b32 v18, 15, v0
  v_lshlrev_b32 v19, 2, v17
  v_xor_b32 v19, v19, v18
  v_lshlrev_b32 v19, 4, v19
  v_lshl_add_u32 v6, v17, 8, v19
  s_cmp_lt_u32 s25, 8
  s_cbranch_scc1 K2_L2
  s_sub_u32 s53, s25, 8
  s_lshl_b32 s3, s53, 2
  v_add_u32 v19, s3, v17
  v_xor_b32 v60, v19, v18
  v_and_b32 v60, 15, v60
  v_lshlrev_b32 v60, 4, v60
  v_lshl_add_u32 v60, v19, 8, v60
  s_mul_i32 s3, s24, 12544
  s_lshl_b32 s55, s53, 10
  s_add_u32 s55, s55, 62720
  s_mov_b32 m0, s55
  s_nop 0
  buffer_load_dwordx4 v60, s[4:7], s3 offen lds
  s_cmp_ge_u32 s25, 13
  s_cbranch_scc1 K2_L3
  s_mov_b32 s54, s25
  s_lshl_b32 s3, s54, 2
  v_add_u32 v19, s3, v17
  v_xor_b32 v60, v19, v18
  v_and_b32 v60, 15, v60
  v_lshlrev_b32 v60, 4, v60
  v_lshl_add_u32 v60, v19, 8, v60
  s_mul_i32 s3, s24, 12544
  s_lshl_b32 s55, s54, 10
  s_add_u32 s55, s55, 62720
  s_mov_b32 m0, s55
  s_nop 0
  buffer_load_dwordx4 v60, s[4:7], s3 offen lds
K2_L3:
  s_lshl_b32 s3, s53, 12
  s_add_u32 s55, s3, 79104
  s_mov_b32 m0, s55
  s_add_u32 s55, s55, 1024
  buffer_load_dwordx4 v6, s[8:11], s3 offen lds
  s_add_u32 s3, s3, 1024
  s_mov_b32 m0, s55
  s_add_u32 s55, s55, 1024
  buffer_load_dwordx4 v6, s[8:11], s3 offen lds
  s_add_u32 s3, s3, 1024
  s_mov_b32 m0, s55
  s_add_u32 s55, s55, 1024
  buffer_load_dwordx4 v6, s[8:11], s3 offen lds
  s_add_u32 s3, s3, 1024
  s_mov_b32 m0, s55
  s_add_u32 s55, s55, 1024
  buffer_load_dwordx4 v6, s[8:11], s3 offen lds
  s_add_u32 s3, s3, 1024
K2_L2:
  s_mov_b32 s14, 32768
  s_mov_b32 s15, 0x00020000
  s_mov_b32 s18, 3200000
  s_mov_b32 s19, 0x00020000
  v_mov_b32 v120, 0
  v_mov_b32 v121, 0
  v_mov_b32 v122, 0
  v_mov_b32 v123, 0
  v_mov_b32 v124, 0
  v_mov_b32 v125, 0
  v_mov_b32 v126, 0
  v_mov_b32 v127, 0
  v_mov_b32 v83, 0
  v_bfe_u32 v19, v21, 2, 1
  v_mul_u32_u24 v19, 12, v19
  v_and_b32 v17, 3, v21
  v_or_b32 v19, v19, v17
  v_lshlrev_b32 v4, 8, v21
  v_lshl_or_b32 v4, v19, 4, v4
  s_and_b32 s32, s25, 3
  s_bfe_u32 s33, s25, 0x10002
  s_cmp_ge_u32 s25, 8
  s_cbranch_scc1 K2_NOQA
  v_bfe_u32 v19, v21, 2, 2
  v_lshrrev_b32 v17, 5, v21
  v_lshl_add_u32 v12, v17, 3, v19
  v_lshlrev_b32 v12, 8, v12
  v_xor_b32 v19, s32, v19
  v_lshl_add_u32 v12, v19, 6, v12
  v_bfe_u32 v19, v21, 4, 1
  v_bfe_u32 v17, v21, 1, 1
  v_lshl_add_u32 v19, v19, 1, v17
  v_and_b32 v17, 1, v21
  v_lshl_add_u32 v19, v17, 2, v19
  v_lshl_add_u32 v12, v19, 3, v12
  v_add_u32 v12, 79104, v12
  v_and_b32 v14, 31, v21
  s_lshl_b32 s3, s33, 5
  v_add_u32 v14, s3, v14
  v_lshrrev_b32 v17, 5, v21
  v_xor_b32 v17, v17, v14
  v_and_b32 v17, 15, v17
  v_lshlrev_b32 v17, 4, v17
  v_lshl_add_u32 v13, v14, 8, v17
  v_bfe_u32 v19, v14, 2, 1
  v_mul_u32_u24 v19, 12, v19
  v_and_b32 v17, 3, v14
  v_or_b32 v19, v19, v17
  v_lshrrev_b32 v17, 5, v21
  s_lshl_b32 s3, s32, 2
  v_lshl_add_u32 v17, v17, 1, s3
  v_xor_b32 v19, v19, v17
  v_lshlrev_b32 v19, 4, v19
  v_lshl_add_u32 v15, v14, 8, v19
K2_NOQA:
  s_movk_i32 s55, 782
  s_cmp_eq_u32 s2, 255
  s_cselect_b32 s55, 590, s55
  v_cmp_gt_u32 vcc, s55, v0
  s_and_saveexec_b64 s[50:51], vcc
  s_cbranch_execz K1_EDGE1_DONE
  s_mov_b32 s55, -49
  s_mov_b32 s52, 46336
  s_cmp_lt_u32 s25, 8
  s_cbranch_scc1 K1_EW0
  s_waitcnt vmcnt(7)
  s_branch K1_EW1
K1_EW0:
  s_waitcnt vmcnt(1)
K1_EW1:
  v_mul_u32_u24 v17, 21400, v56
  v_lshrrev_b32 v17, 20, v17
  v_lshlrev_b32 v62, 2, v17
  v_add_u32 v19, 153344, v62
  ds_add_rtn_u32 v64, v19, v20
  v_mad_i32_i24 v18, v17, s55, v56
  v_lshl_or_b32 v60, v58, 8, v18
  v_mov_b32 v76, v17
  v_lshl_add_u32 v62, v62, 4, s52
  v_mul_u32_u24 v17, 21400, v57
  v_lshrrev_b32 v17, 20, v17
  v_lshlrev_b32 v63, 2, v17
  v_add_u32 v19, 153344, v63
  ds_add_rtn_u32 v65, v19, v20
  v_mad_i32_i24 v18, v17, s55, v57
  v_lshl_or_b32 v61, v59, 8, v18
  v_mov_b32 v77, v17
  v_lshl_add_u32 v63, v63, 4, s52
  v_mov_b32 v19, 154384
  s_waitcnt lgkmcnt(1)
  v_cmp_gt_u32 s[36:37], 16, v64
  v_lshl_add_u32 v17, v64, 2, v62
  s_nop 0
  v_cndmask_b32_e64 v17, v19, v17, s[36:37]
  ds_write_b32 v17, v60
  s_waitcnt lgkmcnt(0)
  v_cmp_gt_u32 s[38:39], 16, v65
  v_lshl_add_u32 v17, v65, 2, v63
  s_nop 0
  v_cndmask_b32_e64 v17, v19, v17, s[38:39]
  ds_write_b32 v17, v61
  s_and_b64 s[40:41], s[36:37], s[38:39]
  s_andn2_b64 s[40:41], exec, s[40:41]
  s_cbranch_scc0 K1_EDGE1_DONE
  s_mov_b64 s[42:43], exec
  s_andn2_b64 exec, s[42:43], s[36:37]
  s_cbranch_execz K1_OV_0
  v_and_b32 v17, 7, v76
  v_lshrrev_b32 v18, 5, v76
  v_lshl_add_u32 v17, v18, 3, v17
  v_lshlrev_b32 v18, 2, v17
  v_add_u32 v18, 154624, v18
  ds_add_rtn_u32 v18, v18, v20
  v_bfe_u32 v19, v76, 3, 2
  v_lshl_or_b32 v19, v19, 6, v60
  v_lshlrev_b32 v17, 4, v17
  v_add_u32 v17, 154880, v17
  s_waitcnt lgkmcnt(0)
  v_cmp_gt_u32 vcc, 4, v18
  v_lshl_add_u32 v17, v18, 2, v17
  s_mov_b64 s[44:45], exec
  s_and_b64 exec, exec, vcc
  ds_write_b32 v17, v19
  s_andn2_b64 exec, s[44:45], vcc
  s_cbranch_execz K1_OV_0
  v_mov_b32 v17, 154368
  ds_add_rtn_u32 v17, v17, v20
  s_waitcnt lgkmcnt(0)
  v_lshlrev_b32 v17, 2, v17
  ds_write_b32 v17, v60 offset:2304
  ds_write_b32 v17, v76 offset:10496
K1_OV_0:
  s_andn2_b64 exec, s[42:43], s[38:39]
  s_cbranch_execz K1_OV_1
  v_and_b32 v17, 7, v77
  v_lshrrev_b32 v18, 5, v77
  v_lshl_add_u32 v17, v18, 3, v17
  v_lshlrev_b32 v18, 2, v17
  v_add_u32 v18, 154624, v18
  ds_add_rtn_u32 v18, v18, v20
  v_bfe_u32 v19, v77, 3, 2
  v_lshl_or_b32 v19, v19, 6, v61
  v_lshlrev_b32 v17, 4, v17
  v_add_u32 v17, 154880, v17
  s_waitcnt lgkmcnt(0)
  v_cmp_gt_u32 vcc, 4, v18
  v_lshl_add_u32 v17, v18, 2, v17
  s_mov_b64 s[44:45], exec
  s_and_b64 exec, exec, vcc
  ds_write_b32 v17, v19
  s_andn2_b64 exec, s[44:45], vcc
  s_cbranch_execz K1_OV_1
  v_mov_b32 v17, 154368
  ds_add_rtn_u32 v17, v17, v20
  s_waitcnt lgkmcnt(0)
  v_lshlrev_b32 v17, 2, v17
  ds_write_b32 v17, v61 offset:2304
  ds_write_b32 v17, v77 offset:10496
K1_OV_1:
K1_EDGE1_DONE:
  s_mov_b64 exec, s[50:51]
  v_lshlrev_b32 v17, 4, v0
  s_waitcnt lgkmcnt(0)
  s_barrier
  s_cmp_ge_u32 s25, 8
  s_cbranch_scc1 K1_NOCOPY
  ds_read_b128 v[68:71], v17 offset:46336
  ds_read_b128 v[72:75], v17 offset:54528
  s_lshl_b32 s3, s31, 6
  s_add_u32 s3, s3, 1048576
  s_add_u32 s55, s3, 2097152
  s_waitcnt vmcnt(0)
  v_readfirstlane_b32 s35, v66
  s_nop 3
  s_and_b32 s30, s35, 4286578688
  s_add_u32 s30, s30, 8388608
  s_waitcnt lgkmcnt(1)
  v_or_b32 v68, s30, v68
  v_or_b32 v69, s30, v69
  v_or_b32 v70, s30, v70
  v_or_b32 v71, s30, v71
  buffer_store_dwordx4 v[68:71], v67, s[20:23], s3 offen sc1
  s_waitcnt lgkmcnt(0)
  v_or_b32 v72, s30, v72
  v_or_b32 v73, s30, v73
  v_or_b32 v74, s30, v74
  v_or_b32 v75, s30, v75
  buffer_store_dwordx4 v[72:75], v67, s[20:23], s55 offen sc1
  s_cmp_eq_u32 s25, 6
  s_cbranch_scc0 K1_NOX
  v_lshlrev_b32 v18, 4, v21
  v_add_u32 v18, 154880, v18
  ds_read_b128 v[56:59], v18
  v_lshlrev_b32 v18, 2, v21
  v_add_u32 v18, 154624, v18
  ds_read_b32 v18, v18
  v_lshlrev_b32 v19, 12, v21
  s_lshl_b32 s3, s31, 4
  s_add_u32 s3, s3, 262144
  v_mov_b32 v20, 4194304
  s_waitcnt lgkmcnt(0)
  v_cmp_lt_u32 vcc, 4, v18
  v_or_b32 v56, s30, v56
  v_or_b32 v57, s30, v57
  v_or_b32 v58, s30, v58
  v_or_b32 v59, s30, v59
  v_cndmask_b32_e64 v20, 0, v20, vcc
  v_or_b32 v59, v20, v59
  buffer_store_dwordx4 v[56:59], v19, s[20:23], s3 offen sc1
K1_NOX:
  s_cmp_eq_u32 s25, 7
  s_cbranch_scc0 K1_DRAIN
  v_mov_b32 v20, 154368
  ds_read_b32 v64, v20
  s_waitcnt lgkmcnt(0)
  v_readfirstlane_b32 s52, v64
  s_nop 3
  s_cmp_eq_u32 s52, 0
  s_cbranch_scc1 K1_DRAIN
  s_min_u32 s52, s52, 1564
  s_lshl_b32 s55, s31, 4
  s_add_u32 s55, s55, 4096
  v_mov_b32 v19, s55
  v_or_b32 v56, s30, v64
  v_mov_b32 v57, v56
  v_mov_b32 v58, v56
  v_mov_b32 v59, v56
  s_mov_b64 exec, 1
  buffer_store_dwordx4 v[56:59], v19, s[20:23], 0 offen sc1
  s_mov_b64 exec, -1
  s_mul_i32 s3, s31, 16384
  s_add_u32 s3, s3, 5242880
  v_mov_b32 v17, v21
K1_OVL:
  v_cmp_gt_u32 vcc, s52, v17
  s_and_b64 exec, exec, vcc
  s_cbranch_execz K1_OVD
  v_lshlrev_b32 v18, 2, v17
  ds_read_b32 v56, v18 offset:2304
  ds_read_b32 v57, v18 offset:10496
  v_lshlrev_b32 v18, 3, v17
  s_waitcnt lgkmcnt(0)
  v_or_b32 v56, s30, v56
  v_or_b32 v57, s30, v57
  buffer_store_dwordx2 v[56:57], v18, s[20:23], s3 offen sc1
  v_add_u32 v17, 64, v17
  s_branch K1_OVL
K1_OVD:
  s_mov_b64 exec, -1
K1_DRAIN:
  s_branch K1_COPIED
K1_NOCOPY:
  s_waitcnt vmcnt(0)
  v_readfirstlane_b32 s35, v66
  s_nop 3
  s_and_b32 s30, s35, 4286578688
  s_add_u32 s30, s30, 8388608
K1_COPIED:
  s_barrier
  s_cmp_ge_u32 s25, 8
  s_cbranch_scc1 K2_NOQ
  ds_read_b64_tr_b16 v[88:89], v12 offset:0
  ds_read_b64_tr_b16 v[90:91], v12 offset:1024
  v_xor_b32 v19, 0, v13
  ds_read_b128 v[40:43], v19 offset:62720
  ds_read_b64_tr_b16 v[92:93], v12 offset:4096
  ds_read_b64_tr_b16 v[94:95], v12 offset:5120
  v_xor_b32 v19, 32, v13
  ds_read_b128 v[44:47], v19 offset:62720
  ds_read_b64_tr_b16 v[96:97], v12 offset:8192
  ds_read_b64_tr_b16 v[98:99], v12 offset:9216
  v_xor_b32 v19, 64, v13
  ds_read_b128 v[48:51], v19 offset:62720
  ds_read_b64_tr_b16 v[100:101], v12 offset:12288
  ds_read_b64_tr_b16 v[102:103], v12 offset:13312
  v_xor_b32 v19, 96, v13
  ds_read_b128 v[52:55], v19 offset:62720
  s_waitcnt lgkmcnt(9)
  v_mfma_f32_32x32x16_bf16 v[24:39], v[88:91], v[40:43], 0
  ds_read_b64_tr_b16 v[104:105], v12 offset:16384
  ds_read_b64_tr_b16 v[106:107], v12 offset:17408
  v_xor_b32 v19, 128, v13
  ds_read_b128 v[40:43], v19 offset:62720
  s_waitcnt lgkmcnt(9)
  v_mfma_f32_32x32x16_bf16 v[24:39], v[92:95], v[44:47], v[24:39]
  ds_read_b64_tr_b16 v[108:109], v12 offset:20480
  ds_read_b64_tr_b16 v[110:111], v12 offset:21504
  v_xor_b32 v19, 160, v13
  ds_read_b128 v[44:47], v19 offset:62720
  s_waitcnt lgkmcnt(9)
  v_mfma_f32_32x32x16_bf16 v[24:39], v[96:99], v[48:51], v[24:39]
  ds_read_b64_tr_b16 v[112:113], v12 offset:24576
  ds_read_b64_tr_b16 v[114:115], v12 offset:25600
  v_xor_b32 v19, 192, v13
  ds_read_b128 v[48:51], v19 offset:62720
  s_waitcnt lgkmcnt(9)
  v_mfma_f32_32x32x16_bf16 v[24:39], v[100:103], v[52:55], v[24:39]
  ds_read_b64_tr_b16 v[116:117], v12 offset:28672
  ds_read_b64_tr_b16 v[118:119], v12 offset:29696
  v_xor_b32 v19, 224, v13
  ds_read_b128 v[52:55], v19 offset:62720
  s_waitcnt lgkmcnt(9)
  v_mfma_f32_32x32x16_bf16 v[24:39], v[104:107], v[40:43], v[24:39]
  s_waitcnt lgkmcnt(6)
  v_mfma_f32_32x32x16_bf16 v[24:39], v[108:111], v[44:47], v[24:39]
  s_waitcnt lgkmcnt(3)
  v_mfma_f32_32x32x16_bf16 v[24:39], v[112:115], v[48:51], v[24:39]
  s_waitcnt lgkmcnt(0)
  v_mfma_f32_32x32x16_bf16 v[24:39], v[116:119], v[52:55], v[24:39]
  v_cmp_gt_u32 vcc, 52, v14
  v_xor_b32 v19, 16, v15
  s_nop 7
  s_nop 2
  v_cvt_pk_bf16_f32 v88, v24, v25
  v_cvt_pk_bf16_f32 v89, v26, v27
  v_cvt_pk_bf16_f32 v90, v28, v29
  v_cvt_pk_bf16_f32 v91, v30, v31
  v_cvt_pk_bf16_f32 v92, v32, v33
  v_cvt_pk_bf16_f32 v93, v34, v35
  v_cvt_pk_bf16_f32 v94, v36, v37
  v_cvt_pk_bf16_f32 v95, v38, v39
  s_mov_b64 exec, vcc
  ds_write_b128 v15, v[88:91] offset:33024
  ds_write_b128 v19, v[92:95] offset:33024
  s_mov_b64 exec, -1
  s_lshl_b32 s3, s25, 12
  s_add_u32 s55, s3, 120576
  s_mov_b32 m0, s55
  s_add_u32 s55, s55, 1024
  buffer_load_dwordx4 v6, s[12:15], s3 offen lds
  s_add_u32 s3, s3, 1024
  s_mov_b32 m0, s55
  s_add_u32 s55, s55, 1024
  buffer_load_dwordx4 v6, s[12:15], s3 offen lds
  s_add_u32 s3, s3, 1024
  s_mov_b32 m0, s55
  s_add_u32 s55, s55, 1024
  buffer_load_dwordx4 v6, s[12:15], s3 offen lds
  s_add_u32 s3, s3, 1024
  s_mov_b32 m0, s55
  s_add_u32 s55, s55, 1024
  buffer_load_dwordx4 v6, s[12:15], s3 offen lds
  s_add_u32 s3, s3, 1024
  s_branch K2_HDRD
K2_NOQ:
  s_sub_u32 s54, s25, 8
  s_lshl_b32 s3, s54, 11
  v_lshlrev_b32 v17, 4, v21
  v_add_u32 v17, s3, v17
  s_lshl_b32 s3, s24, 14
  s_add_u32 s3, s3, 1048576
  s_mov_b32 s55, 131072
  s_mov_b32 s53, 8388608
  s_mov_b32 exec_lo, 0
  s_mov_b32 exec_hi, 0x80000000
K1_CAN:
  buffer_load_dword v18, v17, s[20:23], s3 offen offset:1036 sc1
  s_waitcnt vmcnt(0)
  v_xor_b32 v18, s30, v18
  v_cmp_le_u32 vcc, s53, v18
  s_cbranch_vccz K1_CAND
  s_sleep 2
  s_sub_u32 s55, s55, 1
  s_cmp_lg_u32 s55, 0
  s_cbranch_scc1 K1_CAN
K1_CAND:
  s_mov_b64 exec, -1
  s_mov_b32 s55, 131072
K1_TP:
  buffer_load_dwordx4 v[56:59], v17, s[20:23], s3 offen sc1
  buffer_load_dwordx4 v[60:63], v17, s[20:23], s3 offen offset:1024 sc1
  s_waitcnt vmcnt(0)
  v_xor_b32 v56, s30, v56
  v_xor_b32 v57, s30, v57
  v_xor_b32 v58, s30, v58
  v_xor_b32 v59, s30, v59
  v_xor_b32 v60, s30, v60
  v_xor_b32 v61, s30, v61
  v_xor_b32 v62, s30, v62
  v_xor_b32 v63, s30, v63
  v_or3_b32 v18, v56, v57, v58
  v_or3_b32 v18, v18, v59, v60
  v_or3_b32 v18, v18, v61, v62
  v_or_b32 v18, v18, v63
  v_cmp_le_u32 vcc, s53, v18
  s_and_b64 exec, exec, vcc
  s_cbranch_execz K1_TPD
  s_sleep 2
  s_sub_u32 s55, s55, 1
  s_cmp_lg_u32 s55, 0
  s_cbranch_scc1 K1_TP
K1_TPD:
  s_mov_b64 exec, -1
  v_mov_b32 v64, 63
  v_mov_b32 v65, 63
  v_mov_b32 v66, 63
  v_mov_b32 v67, 63
  s_and_b32 s3, s24, 7
  s_lshr_b32 s52, s24, 5
  s_lshl_b32 s52, s52, 3
  s_add_u32 s3, s3, s52
  s_lshl_b32 s3, s3, 12
  s_lshl_b32 s52, s54, 9
  s_add_u32 s3, s3, s52
  s_add_u32 s3, s3, 262144
  v_lshlrev_b32 v17, 4, v21
  s_mov_b32 s55, 131072
  s_mov_b32 exec_lo, -1
  s_mov_b32 exec_hi, 0
K1_XP:
  buffer_load_dwordx4 v[64:67], v17, s[20:23], s3 offen sc1
  s_waitcnt vmcnt(0)
  v_xor_b32 v64, s30, v64
  v_xor_b32 v65, s30, v65
  v_xor_b32 v66, s30, v66
  v_xor_b32 v67, s30, v67
  v_or3_b32 v18, v64, v65, v66
  v_or_b32 v18, v18, v67
  v_cmp_le_u32 vcc, s53, v18
  s_and_b64 exec, exec, vcc
  s_cbranch_execz K1_XPD
  s_sleep 2
  s_sub_u32 s55, s55, 1
  s_cmp_lg_u32 s55, 0
  s_cbranch_scc1 K1_XP
K1_XPD:
  s_mov_b64 exec, -1
  v_and_b32 v18, 4194304, v67
  v_cmp_ne_u32 vcc, 0, v18
  s_cbranch_vccz K1_NOXP
  s_mov_b64 exec, vcc
  s_lshl_b32 s3, s54, 9
  s_add_u32 s3, s3, 4096
  s_mov_b32 s55, 131072
K1_HP:
  buffer_load_dwordx4 v[104:107], v17, s[20:23], s3 offen sc1
  s_waitcnt vmcnt(0)
  v_xor_b32 v19, s30, v104
  v_xor_b32 v105, v104, v105
  v_xor_b32 v106, v104, v106
  v_xor_b32 v107, v104, v107
  v_or3_b32 v105, v105, v106, v107
  v_cmp_ne_u32 s[36:37], 0, v105
  v_cmp_le_u32 vcc, s53, v19
  s_or_b64 vcc, vcc, s[36:37]
  s_cbranch_vccz K1_HPD
  s_sleep 2
  s_sub_u32 s55, s55, 1
  s_cmp_lg_u32 s55, 0
  s_cbranch_scc1 K1_HP
K1_HPD:
  v_min_u32 v19, 1564, v19
  s_lshl_b32 s3, s54, 7
  s_add_u32 s3, s3, 155904
  v_lshlrev_b32 v18, 2, v21
  v_add_u32 v18, s3, v18
  ds_write_b32 v18, v19
  v_mov_b32 v18, 256
  ds_max_u32 v18, v19
  s_mov_b64 exec, -1
K1_NOXP:
  v_mov_b32 v20, 1
K2_DECODE:
  v_lshlrev_b32 v80, 2, v56
  v_and_b32 v80, 0xfc, v80
  v_cmp_gt_u32 s[36:37], s34, v80
  v_and_b32 v68, 0x003fff00, v56
  v_lshlrev_b32 v81, 2, v57
  v_and_b32 v81, 0xfc, v81
  v_cmp_gt_u32 s[38:39], s34, v81
  v_and_b32 v69, 0x003fff00, v57
  s_mov_b64 exec, s[36:37]
  ds_add_rtn_u32 v92, v80, v20 offset:0
  s_mov_b64 exec, -1
  v_lshlrev_b32 v82, 2, v58
  v_and_b32 v82, 0xfc, v82
  v_cmp_gt_u32 s[40:41], s34, v82
  v_and_b32 v70, 0x003fff00, v58
  s_mov_b64 exec, s[38:39]
  ds_add_rtn_u32 v93, v81, v20 offset:0
  s_mov_b64 exec, -1
  v_lshlrev_b32 v83, 2, v59
  v_and_b32 v83, 0xfc, v83
  v_cmp_gt_u32 s[42:43], s34, v83
  v_and_b32 v71, 0x003fff00, v59
  s_mov_b64 exec, s[40:41]
  ds_add_rtn_u32 v94, v82, v20 offset:0
  s_mov_b64 exec, -1
  v_lshlrev_b32 v84, 2, v60
  v_and_b32 v84, 0xfc, v84
  v_cmp_gt_u32 s[44:45], s34, v84
  v_and_b32 v72, 0x003fff00, v60
  s_mov_b64 exec, s[42:43]
  ds_add_rtn_u32 v95, v83, v20 offset:0
  s_mov_b64 exec, -1
  v_lshlrev_b32 v85, 2, v61
  v_and_b32 v85, 0xfc, v85
  v_cmp_gt_u32 s[46:47], s34, v85
  v_and_b32 v73, 0x003fff00, v61
  s_mov_b64 exec, s[44:45]
  ds_add_rtn_u32 v96, v84, v20 offset:0
  s_mov_b64 exec, -1
  v_lshlrev_b32 v86, 2, v62
  v_and_b32 v86, 0xfc, v86
  v_cmp_gt_u32 s[48:49], s34, v86
  v_and_b32 v74, 0x003fff00, v62
  s_mov_b64 exec, s[46:47]
  ds_add_rtn_u32 v97, v85, v20 offset:0
  s_mov_b64 exec, -1
  v_lshlrev_b32 v87, 2, v63
  v_and_b32 v87, 0xfc, v87
  v_cmp_gt_u32 s[0:1], s34, v87
  v_and_b32 v75, 0x003fff00, v63
  s_mov_b64 exec, s[48:49]
  ds_add_rtn_u32 v98, v86, v20 offset:0
  s_mov_b64 exec, -1
  s_mov_b64 exec, s[0:1]
  ds_add_rtn_u32 v99, v87, v20 offset:0
  s_mov_b64 exec, -1
  s_mov_b64 s[50:51], 0
  s_cmp_eq_u32 s26, 0
  s_cbranch_scc0 K2_HDRD
  v_and_b32 v17, v64, v65
  v_and_b32 v18, v66, v67
  v_and_b32 v17, v17, v18
  v_and_b32 v17, 63, v17
  v_cmp_ne_u32 vcc, 63, v17
  s_cbranch_vccz K2_HDRD
  s_bfe_u32 s55, s24, 0x20003
  v_bfe_u32 v17, v64, 6, 2
  v_cmp_eq_u32 vcc, s55, v17
  v_mov_b32 v18, 63
  v_and_b32 v19, 0x003fff3f, v64
  s_nop 0
  v_cndmask_b32_e64 v64, v18, v19, vcc
  v_lshlrev_b32 v88, 2, v64
  v_and_b32 v88, 0xfc, v88
  v_cmp_gt_u32 s[56:57], s34, v88
  v_and_b32 v76, 0x003fff00, v64
  v_bfe_u32 v17, v65, 6, 2
  v_cmp_eq_u32 vcc, s55, v17
  v_mov_b32 v18, 63
  v_and_b32 v19, 0x003fff3f, v65
  s_nop 0
  v_cndmask_b32_e64 v65, v18, v19, vcc
  v_lshlrev_b32 v89, 2, v65
  v_and_b32 v89, 0xfc, v89
  v_cmp_gt_u32 s[58:59], s34, v89
  v_and_b32 v77, 0x003fff00, v65
  v_bfe_u32 v17, v66, 6, 2
  v_cmp_eq_u32 vcc, s55, v17
  v_mov_b32 v18, 63
  v_and_b32 v19, 0x003fff3f, v66
  s_nop 0
  v_cndmask_b32_e64 v66, v18, v19, vcc
  v_lshlrev_b32 v90, 2, v66
  v_and_b32 v90, 0xfc, v90
  v_cmp_gt_u32 s[60:61], s34, v90
  v_and_b32 v78, 0x003fff00, v66
  v_bfe_u32 v17, v67, 6, 2
  v_cmp_eq_u32 vcc, s55, v17
  v_mov_b32 v18, 63
  v_and_b32 v19, 0x003fff3f, v67
  s_nop 0
  v_cndmask_b32_e64 v67, v18, v19, vcc
  v_lshlrev_b32 v91, 2, v67
  v_and_b32 v91, 0xfc, v91
  v_cmp_gt_u32 s[62:63], s34, v91
  v_and_b32 v79, 0x003fff00, v67
  s_or_b64 s[50:51], s[56:57], s[58:59]
  s_or_b64 s[50:51], s[50:51], s[60:61]
  s_or_b64 s[50:51], s[50:51], s[62:63]
  s_cbranch_scc0 K2_HDRD
  s_mov_b64 exec, s[56:57]
  ds_add_rtn_u32 v100, v88, v20 offset:0
  s_mov_b64 exec, s[58:59]
  ds_add_rtn_u32 v101, v89, v20 offset:0
  s_mov_b64 exec, s[60:61]
  ds_add_rtn_u32 v102, v90, v20 offset:0
  s_mov_b64 exec, s[62:63]
  ds_add_rtn_u32 v103, v91, v20 offset:0
  s_mov_b64 exec, -1
K2_HDRD:
  s_waitcnt lgkmcnt(0)
  s_barrier
  s_cmp_ge_u32 s25, 8
  s_cbranch_scc1 K2_NOPF5
  s_waitcnt vmcnt(0)
  s_sub_u32 s3, s25, 5
  s_cmp_ge_u32 s3, 3
  s_cbranch_scc1 K2_NOPF5
  s_lshl_b32 s55, s3, 13
  s_lshr_b32 s3, s2, 3
  s_mul_i32 s3, s3, 100096
  s_add_u32 s3, s3, s55
  v_lshlrev_b32 v17, 7, v21
  buffer_load_dword v16, v17, s[4:7], s3 offen
K2_NOPF5:
  v_lshlrev_b32 v19, 2, v21
  ds_read_b32 v112, v19 offset:0
  s_lshl_b32 s55, s25, 2
  s_waitcnt lgkmcnt(0)
  v_add_u32 v23, 3, v112
  v_and_b32 v23, -4, v23
  v_mov_b32 v22, v23
  v_cmp_lt_u32 vcc, s55, v23
  s_nop 0
  v_add_u32_dpp v22, v22, v22 row_shr:1 row_mask:0xf bank_mask:0xf bound_ctrl:1
  s_nop 1
  v_add_u32_dpp v22, v22, v22 row_shr:2 row_mask:0xf bank_mask:0xf bound_ctrl:1
  s_nop 1
  v_add_u32_dpp v22, v22, v22 row_shr:4 row_mask:0xf bank_mask:0xf bound_ctrl:1
  s_nop 1
  v_add_u32_dpp v22, v22, v22 row_shr:8 row_mask:0xf bank_mask:0xf bound_ctrl:1
  s_nop 1
  v_add_u32_dpp v22, v22, v22 row_bcast:15 row_mask:0xa bank_mask:0xf
  s_nop 1
  v_add_u32_dpp v22, v22, v22 row_bcast:31 row_mask:0xc bank_mask:0xf
  s_nop 0
  v_readlane_b32 s52, v22, 63
  v_sub_u32 v22, v22, v23
  s_cmp_lt_u32 s25, 8
  s_cbranch_scc1 K2_NOBP
  ds_bpermute_b32 v104, v80, v22
  ds_bpermute_b32 v105, v81, v22
  ds_bpermute_b32 v106, v82, v22
  ds_bpermute_b32 v107, v83, v22
  ds_bpermute_b32 v108, v84, v22
  ds_bpermute_b32 v109, v85, v22
  ds_bpermute_b32 v110, v86, v22
  ds_bpermute_b32 v111, v87, v22
K2_NOBP:
  v_add_u32 v17, s55, v22
  s_mov_b64 exec, vcc
  ds_write_b32 v17, v4 offset:26880
  s_mov_b64 exec, -1
  v_cmp_lt_u32 vcc, 64, v23
  s_cbranch_vccz K2_UND
K2_UN:
  s_add_u32 s55, s55, 64
  v_cmp_lt_u32 vcc, s55, v23
  s_cbranch_vccz K2_UND
  v_add_u32 v17, s55, v22
  s_mov_b64 exec, vcc
  ds_write_b32 v17, v4 offset:26880
  s_mov_b64 exec, -1
  s_branch K2_UN
K2_UND:
  s_cmp_gt_u32 s25, 4
  s_cbranch_scc1 K2_NOPAD
  v_mov_b32 v19, 1073741824
  s_cmp_gt_u32 s25, 2
  s_cbranch_scc1 K2_TAILPAD
  v_sub_u32 v18, v23, v112
  v_add_u32 v17, v22, v112
  v_cmp_lt_u32 vcc, s25, v18
  v_add_u32 v17, s25, v17
  v_lshlrev_b32 v17, 2, v17
  s_mov_b64 exec, vcc
  ds_write_b32 v17, v19 offset:2304
  s_mov_b64 exec, -1
  s_branch K2_NOPAD
K2_TAILPAD:
  v_lshlrev_b32 v18, 2, v21
  s_cmp_eq_u32 s25, 3
  s_cbranch_scc0 K2_TAILU
  s_lshl_b32 s55, s52, 2
  v_add_u32 v17, s55, v18
  s_mov_b64 exec, 0xfffffff
  ds_write_b32 v17, v19 offset:2304
  s_mov_b64 exec, -1
  s_branch K2_NOPAD
K2_TAILU:
  v_add_u32 v17, s52, v18
  v_mov_b32 v19, 12560
  s_mov_b64 exec, 0x7f
  ds_write_b32 v17, v19 offset:26880
  s_mov_b64 exec, -1
K2_NOPAD:
  s_add_u32 s3, s52, 31
  s_lshr_b32 s3, s3, 5
  s_lshr_b32 s53, s3, 4
  s_and_b32 s54, s3, 15
  s_cmp_lt_u32 s25, s54
  s_cselect_b32 s33, 1, 0
  s_add_u32 s31, s53, s33
  s_min_u32 s3, s54, s25
  s_mul_i32 s55, s53, s25
  s_add_u32 s55, s55, s3
  v_lshrrev_b32 v17, 4, v21
  s_lshl_b32 s3, s31, 1
  v_mul_u32_u24 v17, s3, v17
  s_lshl_b32 s3, s55, 3
  v_add_u32 v17, s3, v17
  v_lshlrev_b32 v3, 4, v17
  v_lshlrev_b32 v4, 2, v17
  s_cmp_lt_u32 s25, 8
  s_cbranch_scc1 K2_SC_Q
  s_waitcnt lgkmcnt(0)
  v_add_lshl_u32 v104, v104, v92, 2
  v_add_lshl_u32 v105, v105, v93, 2
  v_add_lshl_u32 v106, v106, v94, 2
  v_add_lshl_u32 v107, v107, v95, 2
  v_add_lshl_u32 v108, v108, v96, 2
  v_add_lshl_u32 v109, v109, v97, 2
  v_add_lshl_u32 v110, v110, v98, 2
  v_add_lshl_u32 v111, v111, v99, 2
  s_mov_b64 exec, s[36:37]
  ds_write_b32 v104, v68 offset:2304
  s_mov_b64 exec, s[38:39]
  ds_write_b32 v105, v69 offset:2304
  s_mov_b64 exec, s[40:41]
  ds_write_b32 v106, v70 offset:2304
  s_mov_b64 exec, s[42:43]
  ds_write_b32 v107, v71 offset:2304
  s_mov_b64 exec, s[44:45]
  ds_write_b32 v108, v72 offset:2304
  s_mov_b64 exec, s[46:47]
  ds_write_b32 v109, v73 offset:2304
  s_mov_b64 exec, s[48:49]
  ds_write_b32 v110, v74 offset:2304
  s_mov_b64 exec, s[0:1]
  ds_write_b32 v111, v75 offset:2304
  s_mov_b64 exec, -1
  s_cmp_eq_u64 s[50:51], 0
  s_cbranch_scc1 K2_SORT_DONE
  ds_bpermute_b32 v104, v88, v22
  ds_bpermute_b32 v105, v89, v22
  ds_bpermute_b32 v106, v90, v22
  ds_bpermute_b32 v107, v91, v22
  s_waitcnt lgkmcnt(0)
  v_add_lshl_u32 v104, v104, v100, 2
  s_mov_b64 exec, s[56:57]
  ds_write_b32 v104, v76 offset:2304
  s_mov_b64 exec, -1
  v_add_lshl_u32 v105, v105, v101, 2
  s_mov_b64 exec, s[58:59]
  ds_write_b32 v105, v77 offset:2304
  s_mov_b64 exec, -1
  v_add_lshl_u32 v106, v106, v102, 2
  s_mov_b64 exec, s[60:61]
  ds_write_b32 v106, v78 offset:2304
  s_mov_b64 exec, -1
  v_add_lshl_u32 v107, v107, v103, 2
  s_mov_b64 exec, s[62:63]
  ds_write_b32 v107, v79 offset:2304
  s_mov_b64 exec, -1
  s_branch K2_SORT_DONE
K2_SC_Q:
K2_SORT_DONE:
  s_waitcnt lgkmcnt(0)
  s_barrier
  s_setprio 3
  s_cmp_eq_u32 s31, 0
  s_cbranch_scc1 K2_NOMAIN
  ds_read_b128 v[40:43], v3 offset:2304
  ds_read_b128 v[44:47], v3 offset:2320
  ds_read_b64 v[8:9], v4 offset:26880
  v_and_b32 v17, 15, v21
  v_and_b32 v18, 7, v17
  v_lshl_add_u32 v3, v18, 2, v3
  v_add_u32 v3, 2336, v3
  v_and_b32 v18, 1, v17
  v_lshl_add_u32 v4, v18, 2, v4
  v_add_u32 v4, 26888, v4
  v_lshrrev_b32 v18, 1, v17
  v_cmp_eq_u32 vcc, 4, v18
  v_mov_b32 v19, 32
  s_nop 0
  v_cndmask_b32_e64 v3, v3, v4, vcc
  v_cndmask_b32_e64 v4, v19, 8, vcc
  v_mov_b32 v24, 0
  v_mov_b32 v25, 0
  v_mov_b32 v26, 0
  v_mov_b32 v27, 0
  v_mov_b32 v28, 0
  v_mov_b32 v29, 0
  v_mov_b32 v30, 0
  v_mov_b32 v31, 0
  s_waitcnt lgkmcnt(1)
  v_add_u32 v40, v40, v1
  buffer_load_dwordx4 v[56:59], v40, s[4:7], 0 offen
  s_waitcnt lgkmcnt(0)
  v_xor_b32 v17, v8, v1
  v_xor_b32 v18, v9, v1
  ds_read_b128 v[48:51], v17 offset:33024
  ds_read_b128 v[52:55], v18 offset:33024
  v_mov_b32 v5, v8
  v_add_u32 v41, v41, v1
  buffer_load_dwordx4 v[60:63], v41, s[4:7], 0 offen
  v_add_u32 v42, v42, v1
  buffer_load_dwordx4 v[64:67], v42, s[4:7], 0 offen
  v_add_u32 v43, v43, v1
  buffer_load_dwordx4 v[68:71], v43, s[4:7], 0 offen
  v_add_u32 v44, v44, v1
  buffer_load_dwordx4 v[72:75], v44, s[4:7], 0 offen
  v_add_u32 v45, v45, v1
  buffer_load_dwordx4 v[76:79], v45, s[4:7], 0 offen
  v_add_u32 v46, v46, v1
  buffer_load_dwordx4 v[80:83], v46, s[4:7], 0 offen
  v_add_u32 v47, v47, v1
  buffer_load_dwordx4 v[84:87], v47, s[4:7], 0 offen
  s_cmp_eq_u32 s31, 1
  s_cbranch_scc1 K2_LAST
K2_LOOP:
  s_cmp_ge_u32 s31, 3
  s_cbranch_scc1 K2_PR0
  s_setprio 2
K2_PR0:
  s_waitcnt lgkmcnt(0)
  ds_read_b32 v10, v3
  v_add_u32 v3, v3, v4
  s_waitcnt vmcnt(4)
  v_dot2_f32_bf16 v32, v56, v48, 0
  v_dot2_f32_bf16 v33, v60, v48, 0
  v_dot2_f32_bf16 v34, v64, v48, 0
  v_dot2_f32_bf16 v35, v68, v48, 0
  v_dot2c_f32_bf16 v32, v57, v49
  v_dot2c_f32_bf16 v33, v61, v49
  v_dot2c_f32_bf16 v34, v65, v49
  v_dot2c_f32_bf16 v35, v69, v49
  v_dot2c_f32_bf16 v32, v58, v50
  v_dot2c_f32_bf16 v33, v62, v50
  v_dot2c_f32_bf16 v34, v66, v50
  v_dot2c_f32_bf16 v35, v70, v50
  v_dot2c_f32_bf16 v32, v59, v51
  v_dot2c_f32_bf16 v33, v63, v51
  v_dot2c_f32_bf16 v34, v67, v51
  v_dot2c_f32_bf16 v35, v71, v51
  s_waitcnt vmcnt(0)
  v_dot2_f32_bf16 v36, v72, v52, 0
  v_dot2_f32_bf16 v37, v76, v52, 0
  v_dot2_f32_bf16 v38, v80, v52, 0
  v_dot2_f32_bf16 v39, v84, v52, 0
  v_dot2c_f32_bf16 v36, v73, v53
  v_dot2c_f32_bf16 v37, v77, v53
  v_dot2c_f32_bf16 v38, v81, v53
  v_dot2c_f32_bf16 v39, v85, v53
  v_dot2c_f32_bf16 v36, v74, v54
  v_dot2c_f32_bf16 v37, v78, v54
  v_dot2c_f32_bf16 v38, v82, v54
  v_dot2c_f32_bf16 v39, v86, v54
  v_dot2c_f32_bf16 v36, v75, v55
  v_dot2c_f32_bf16 v37, v79, v55
  v_dot2c_f32_bf16 v38, v83, v55
  v_dot2c_f32_bf16 v39, v87, v55
  s_waitcnt lgkmcnt(0)
  v_xor_b32_dpp v17, v10, v1 row_newbcast:8 row_mask:0xf bank_mask:0xf
  v_xor_b32_dpp v18, v10, v1 row_newbcast:9 row_mask:0xf bank_mask:0xf
  v_add_u32_dpp v40, v10, v1 row_newbcast:0 row_mask:0xf bank_mask:0xf
  v_add_f32_dpp v32, v32, v32 row_mirror row_mask:0xf bank_mask:0x3
  v_add_f32_dpp v33, v33, v33 row_mirror row_mask:0xf bank_mask:0x3
  v_add_f32_dpp v34, v34, v34 row_mirror row_mask:0xf bank_mask:0x3
  v_add_f32_dpp v35, v35, v35 row_mirror row_mask:0xf bank_mask:0x3
  ds_read_b128 v[48:51], v17 offset:33024
  ds_read_b128 v[52:55], v18 offset:33024
  v_add_f32_dpp v32, v36, v36 row_mirror row_mask:0xf bank_mask:0xc
  v_add_f32_dpp v33, v37, v37 row_mirror row_mask:0xf bank_mask:0xc
  v_add_f32_dpp v34, v38, v38 row_mirror row_mask:0xf bank_mask:0xc
  v_add_f32_dpp v35, v39, v39 row_mirror row_mask:0xf bank_mask:0xc
  v_add_f32_dpp v32, v32, v32 row_half_mirror row_mask:0xf bank_mask:0x5
  v_add_f32_dpp v33, v33, v33 row_half_mirror row_mask:0xf bank_mask:0x5
  v_add_f32_dpp v32, v34, v34 row_half_mirror row_mask:0xf bank_mask:0xa
  v_add_f32_dpp v33, v35, v35 row_half_mirror row_mask:0xf bank_mask:0xa
  v_add_u32_dpp v41, v10, v1 row_newbcast:1 row_mask:0xf bank_mask:0xf
  v_add_f32_dpp v34, v32, v32 quad_perm:[1,0,3,2] row_mask:0xf bank_mask:0xf
  v_add_f32_dpp v35, v33, v33 quad_perm:[1,0,3,2] row_mask:0xf bank_mask:0xf
  v_cndmask_b32_e64 v32, v34, v35, s[28:29]
  v_add_u32_dpp v42, v10, v1 row_newbcast:2 row_mask:0xf bank_mask:0xf
  v_add_u32_dpp v43, v10, v1 row_newbcast:3 row_mask:0xf bank_mask:0xf
  v_add_f32_dpp v32, v32, v32 quad_perm:[2,3,0,1] row_mask:0xf bank_mask:0xf
  v_mul_f32 v32, 0xbe0293ee, v32
  v_exp_f32 v32, v32
  v_add_u32_dpp v44, v10, v1 row_newbcast:4 row_mask:0xf bank_mask:0xf
  v_add_f32 v32, 1.0, v32
  v_rcp_f32 v32, v32
  v_add_u32_dpp v45, v10, v1 row_newbcast:5 row_mask:0xf bank_mask:0xf
  v_cvt_pk_bf16_f32 v12, v32, 0
  v_cvt_pk_bf16_f32 v13, 0, v32
  v_add_u32_dpp v46, v10, v1 row_newbcast:6 row_mask:0xf bank_mask:0xf
  v_add_u32_dpp v47, v10, v1 row_newbcast:7 row_mask:0xf bank_mask:0xf
  s_nop 0
  v_cmp_ne_u32 vcc, v8, v5
  s_cbranch_vccz K2_FL0
  s_mov_b64 exec, vcc
  v_and_b32 v17, 0xffffff00, v5
  v_lshl_add_u32 v17, v17, 1, v2
  ds_write_b128 v17, v[24:27]
  ds_write_b128 v17, v[28:31] offset:256
  v_mov_b32 v24, 0
  v_mov_b32 v25, 0
  v_mov_b32 v26, 0
  v_mov_b32 v27, 0
  v_mov_b32 v28, 0
  v_mov_b32 v29, 0
  v_mov_b32 v30, 0
  v_mov_b32 v31, 0
  s_mov_b64 exec, -1
K2_FL0:
  v_dot2c_f32_bf16_dpp v24, v12, v56 row_newbcast:0 row_mask:0xf bank_mask:0xf
  v_dot2c_f32_bf16_dpp v25, v13, v56 row_newbcast:0 row_mask:0xf bank_mask:0xf
  v_dot2c_f32_bf16_dpp v26, v12, v57 row_newbcast:0 row_mask:0xf bank_mask:0xf
  v_dot2c_f32_bf16_dpp v27, v13, v57 row_newbcast:0 row_mask:0xf bank_mask:0xf
  v_dot2c_f32_bf16_dpp v28, v12, v58 row_newbcast:0 row_mask:0xf bank_mask:0xf
  v_dot2c_f32_bf16_dpp v29, v13, v58 row_newbcast:0 row_mask:0xf bank_mask:0xf
  v_dot2c_f32_bf16_dpp v30, v12, v59 row_newbcast:0 row_mask:0xf bank_mask:0xf
  v_dot2c_f32_bf16_dpp v31, v13, v59 row_newbcast:0 row_mask:0xf bank_mask:0xf
  buffer_load_dwordx4 v[56:59], v40, s[4:7], 0 offen
  v_dot2c_f32_bf16_dpp v24, v12, v60 row_newbcast:1 row_mask:0xf bank_mask:0xf
  v_dot2c_f32_bf16_dpp v25, v13, v60 row_newbcast:1 row_mask:0xf bank_mask:0xf
  v_dot2c_f32_bf16_dpp v26, v12, v61 row_newbcast:1 row_mask:0xf bank_mask:0xf
  v_dot2c_f32_bf16_dpp v27, v13, v61 row_newbcast:1 row_mask:0xf bank_mask:0xf
  v_dot2c_f32_bf16_dpp v28, v12, v62 row_newbcast:1 row_mask:0xf bank_mask:0xf
  v_dot2c_f32_bf16_dpp v29, v13, v62 row_newbcast:1 row_mask:0xf bank_mask:0xf
  v_dot2c_f32_bf16_dpp v30, v12, v63 row_newbcast:1 row_mask:0xf bank_mask:0xf
  v_dot2c_f32_bf16_dpp v31, v13, v63 row_newbcast:1 row_mask:0xf bank_mask:0xf
  buffer_load_dwordx4 v[60:63], v41, s[4:7], 0 offen
  v_dot2c_f32_bf16_dpp v24, v12, v64 row_newbcast:4 row_mask:0xf bank_mask:0xf
  v_dot2c_f32_bf16_dpp v25, v13, v64 row_newbcast:4 row_mask:0xf bank_mask:0xf
  v_dot2c_f32_bf16_dpp v26, v12, v65 row_newbcast:4 row_mask:0xf bank_mask:0xf
  v_dot2c_f32_bf16_dpp v27, v13, v65 row_newbcast:4 row_mask:0xf bank_mask:0xf
  v_dot2c_f32_bf16_dpp v28, v12, v66 row_newbcast:4 row_mask:0xf bank_mask:0xf
  v_dot2c_f32_bf16_dpp v29, v13, v66 row_newbcast:4 row_mask:0xf bank_mask:0xf
  v_dot2c_f32_bf16_dpp v30, v12, v67 row_newbcast:4 row_mask:0xf bank_mask:0xf
  v_dot2c_f32_bf16_dpp v31, v13, v67 row_newbcast:4 row_mask:0xf bank_mask:0xf
  buffer_load_dwordx4 v[64:67], v42, s[4:7], 0 offen
  v_dot2c_f32_bf16_dpp v24, v12, v68 row_newbcast:5 row_mask:0xf bank_mask:0xf
  v_dot2c_f32_bf16_dpp v25, v13, v68 row_newbcast:5 row_mask:0xf bank_mask:0xf
  v_dot2c_f32_bf16_dpp v26, v12, v69 row_newbcast:5 row_mask:0xf bank_mask:0xf
  v_dot2c_f32_bf16_dpp v27, v13, v69 row_newbcast:5 row_mask:0xf bank_mask:0xf
  v_dot2c_f32_bf16_dpp v28, v12, v70 row_newbcast:5 row_mask:0xf bank_mask:0xf
  v_dot2c_f32_bf16_dpp v29, v13, v70 row_newbcast:5 row_mask:0xf bank_mask:0xf
  v_dot2c_f32_bf16_dpp v30, v12, v71 row_newbcast:5 row_mask:0xf bank_mask:0xf
  v_dot2c_f32_bf16_dpp v31, v13, v71 row_newbcast:5 row_mask:0xf bank_mask:0xf
  buffer_load_dwordx4 v[68:71], v43, s[4:7], 0 offen
  s_nop 1
  v_cmp_ne_u32 vcc, v9, v8
  s_cbranch_vccz K2_FL1
  s_mov_b64 exec, vcc
  v_and_b32 v17, 0xffffff00, v8
  v_lshl_add_u32 v17, v17, 1, v2
  ds_write_b128 v17, v[24:27]
  ds_write_b128 v17, v[28:31] offset:256
  v_mov_b32 v24, 0
  v_mov_b32 v25, 0
  v_mov_b32 v26, 0
  v_mov_b32 v27, 0
  v_mov_b32 v28, 0
  v_mov_b32 v29, 0
  v_mov_b32 v30, 0
  v_mov_b32 v31, 0
  s_mov_b64 exec, -1
K2_FL1:
  v_dot2c_f32_bf16_dpp v24, v12, v72 row_newbcast:8 row_mask:0xf bank_mask:0xf
  v_dot2c_f32_bf16_dpp v25, v13, v72 row_newbcast:8 row_mask:0xf bank_mask:0xf
  v_dot2c_f32_bf16_dpp v26, v12, v73 row_newbcast:8 row_mask:0xf bank_mask:0xf
  v_dot2c_f32_bf16_dpp v27, v13, v73 row_newbcast:8 row_mask:0xf bank_mask:0xf
  v_dot2c_f32_bf16_dpp v28, v12, v74 row_newbcast:8 row_mask:0xf bank_mask:0xf
  v_dot2c_f32_bf16_dpp v29, v13, v74 row_newbcast:8 row_mask:0xf bank_mask:0xf
  v_dot2c_f32_bf16_dpp v30, v12, v75 row_newbcast:8 row_mask:0xf bank_mask:0xf
  v_dot2c_f32_bf16_dpp v31, v13, v75 row_newbcast:8 row_mask:0xf bank_mask:0xf
  buffer_load_dwordx4 v[72:75], v44, s[4:7], 0 offen
  v_dot2c_f32_bf16_dpp v24, v12, v76 row_newbcast:9 row_mask:0xf bank_mask:0xf
  v_dot2c_f32_bf16_dpp v25, v13, v76 row_newbcast:9 row_mask:0xf bank_mask:0xf
  v_dot2c_f32_bf16_dpp v26, v12, v77 row_newbcast:9 row_mask:0xf bank_mask:0xf
  v_dot2c_f32_bf16_dpp v27, v13, v77 row_newbcast:9 row_mask:0xf bank_mask:0xf
  v_dot2c_f32_bf16_dpp v28, v12, v78 row_newbcast:9 row_mask:0xf bank_mask:0xf
  v_dot2c_f32_bf16_dpp v29, v13, v78 row_newbcast:9 row_mask:0xf bank_mask:0xf
  v_dot2c_f32_bf16_dpp v30, v12, v79 row_newbcast:9 row_mask:0xf bank_mask:0xf
  v_dot2c_f32_bf16_dpp v31, v13, v79 row_newbcast:9 row_mask:0xf bank_mask:0xf
  buffer_load_dwordx4 v[76:79], v45, s[4:7], 0 offen
  v_dot2c_f32_bf16_dpp v24, v12, v80 row_newbcast:12 row_mask:0xf bank_mask:0xf
  v_dot2c_f32_bf16_dpp v25, v13, v80 row_newbcast:12 row_mask:0xf bank_mask:0xf
  v_dot2c_f32_bf16_dpp v26, v12, v81 row_newbcast:12 row_mask:0xf bank_mask:0xf
  v_dot2c_f32_bf16_dpp v27, v13, v81 row_newbcast:12 row_mask:0xf bank_mask:0xf
  v_dot2c_f32_bf16_dpp v28, v12, v82 row_newbcast:12 row_mask:0xf bank_mask:0xf
  v_dot2c_f32_bf16_dpp v29, v13, v82 row_newbcast:12 row_mask:0xf bank_mask:0xf
  v_dot2c_f32_bf16_dpp v30, v12, v83 row_newbcast:12 row_mask:0xf bank_mask:0xf
  v_dot2c_f32_bf16_dpp v31, v13, v83 row_newbcast:12 row_mask:0xf bank_mask:0xf
  buffer_load_dwordx4 v[80:83], v46, s[4:7], 0 offen
  v_dot2c_f32_bf16_dpp v24, v12, v84 row_newbcast:13 row_mask:0xf bank_mask:0xf
  v_dot2c_f32_bf16_dpp v25, v13, v84 row_newbcast:13 row_mask:0xf bank_mask:0xf
  v_dot2c_f32_bf16_dpp v26, v12, v85 row_newbcast:13 row_mask:0xf bank_mask:0xf
  v_dot2c_f32_bf16_dpp v27, v13, v85 row_newbcast:13 row_mask:0xf bank_mask:0xf
  v_dot2c_f32_bf16_dpp v28, v12, v86 row_newbcast:13 row_mask:0xf bank_mask:0xf
  v_dot2c_f32_bf16_dpp v29, v13, v86 row_newbcast:13 row_mask:0xf bank_mask:0xf
  v_dot2c_f32_bf16_dpp v30, v12, v87 row_newbcast:13 row_mask:0xf bank_mask:0xf
  v_dot2c_f32_bf16_dpp v31, v13, v87 row_newbcast:13 row_mask:0xf bank_mask:0xf
  buffer_load_dwordx4 v[84:87], v47, s[4:7], 0 offen
  v_mov_b32 v5, v9
  v_mov_b32_dpp v8, v10 row_newbcast:8 row_mask:0xf bank_mask:0xf
  v_mov_b32_dpp v9, v10 row_newbcast:9 row_mask:0xf bank_mask:0xf
  s_sub_u32 s31, s31, 1
  s_cmp_gt_u32 s31, 1
  s_cbranch_scc1 K2_LOOP
K2_LAST:
  s_setprio 1
  s_waitcnt lgkmcnt(0)
  s_waitcnt vmcnt(4)
  v_dot2_f32_bf16 v32, v56, v48, 0
  v_dot2_f32_bf16 v33, v60, v48, 0
  v_dot2_f32_bf16 v34, v64, v48, 0
  v_dot2_f32_bf16 v35, v68, v48, 0
  v_dot2c_f32_bf16 v32, v57, v49
  v_dot2c_f32_bf16 v33, v61, v49
  v_dot2c_f32_bf16 v34, v65, v49
  v_dot2c_f32_bf16 v35, v69, v49
  v_dot2c_f32_bf16 v32, v58, v50
  v_dot2c_f32_bf16 v33, v62, v50
  v_dot2c_f32_bf16 v34, v66, v50
  v_dot2c_f32_bf16 v35, v70, v50
  v_dot2c_f32_bf16 v32, v59, v51
  v_dot2c_f32_bf16 v33, v63, v51
  v_dot2c_f32_bf16 v34, v67, v51
  v_dot2c_f32_bf16 v35, v71, v51
  s_waitcnt vmcnt(0)
  v_dot2_f32_bf16 v36, v72, v52, 0
  v_dot2_f32_bf16 v37, v76, v52, 0
  v_dot2_f32_bf16 v38, v80, v52, 0
  v_dot2_f32_bf16 v39, v84, v52, 0
  v_dot2c_f32_bf16 v36, v73, v53
  v_dot2c_f32_bf16 v37, v77, v53
  v_dot2c_f32_bf16 v38, v81, v53
  v_dot2c_f32_bf16 v39, v85, v53
  v_dot2c_f32_bf16 v36, v74, v54
  v_dot2c_f32_bf16 v37, v78, v54
  v_dot2c_f32_bf16 v38, v82, v54
  v_dot2c_f32_bf16 v39, v86, v54
  v_dot2c_f32_bf16 v36, v75, v55
  v_dot2c_f32_bf16 v37, v79, v55
  v_dot2c_f32_bf16 v38, v83, v55
  v_dot2c_f32_bf16 v39, v87, v55
  s_nop 2
  v_add_f32_dpp v32, v32, v32 row_mirror row_mask:0xf bank_mask:0x3
  v_add_f32_dpp v33, v33, v33 row_mirror row_mask:0xf bank_mask:0x3
  v_add_f32_dpp v34, v34, v34 row_mirror row_mask:0xf bank_mask:0x3
  v_add_f32_dpp v35, v35, v35 row_mirror row_mask:0xf bank_mask:0x3
  v_add_f32_dpp v32, v36, v36 row_mirror row_mask:0xf bank_mask:0xc
  v_add_f32_dpp v33, v37, v37 row_mirror row_mask:0xf bank_mask:0xc
  v_add_f32_dpp v34, v38, v38 row_mirror row_mask:0xf bank_mask:0xc
  v_add_f32_dpp v35, v39, v39 row_mirror row_mask:0xf bank_mask:0xc
  v_add_f32_dpp v32, v32, v32 row_half_mirror row_mask:0xf bank_mask:0x5
  v_add_f32_dpp v33, v33, v33 row_half_mirror row_mask:0xf bank_mask:0x5
  v_add_f32_dpp v32, v34, v34 row_half_mirror row_mask:0xf bank_mask:0xa
  v_add_f32_dpp v33, v35, v35 row_half_mirror row_mask:0xf bank_mask:0xa
  s_nop 0
  v_add_f32_dpp v34, v32, v32 quad_perm:[1,0,3,2] row_mask:0xf bank_mask:0xf
  v_add_f32_dpp v35, v33, v33 quad_perm:[1,0,3,2] row_mask:0xf bank_mask:0xf
  v_cndmask_b32_e64 v32, v34, v35, s[28:29]
  s_nop 0
  s_nop 0
  v_add_f32_dpp v32, v32, v32 quad_perm:[2,3,0,1] row_mask:0xf bank_mask:0xf
  v_mul_f32 v32, 0xbe0293ee, v32
  v_exp_f32 v32, v32
  s_nop 0
  v_add_f32 v32, 1.0, v32
  v_rcp_f32 v32, v32
  s_nop 0
  v_cvt_pk_bf16_f32 v12, v32, 0
  v_cvt_pk_bf16_f32 v13, 0, v32
  s_nop 0
  v_cmp_ne_u32 vcc, v8, v5
  s_cbranch_vccz K2_FL2
  s_mov_b64 exec, vcc
  v_and_b32 v17, 0xffffff00, v5
  v_lshl_add_u32 v17, v17, 1, v2
  ds_write_b128 v17, v[24:27]
  ds_write_b128 v17, v[28:31] offset:256
  v_mov_b32 v24, 0
  v_mov_b32 v25, 0
  v_mov_b32 v26, 0
  v_mov_b32 v27, 0
  v_mov_b32 v28, 0
  v_mov_b32 v29, 0
  v_mov_b32 v30, 0
  v_mov_b32 v31, 0
  s_mov_b64 exec, -1
K2_FL2:
  v_dot2c_f32_bf16_dpp v24, v12, v56 row_newbcast:0 row_mask:0xf bank_mask:0xf
  v_dot2c_f32_bf16_dpp v25, v13, v56 row_newbcast:0 row_mask:0xf bank_mask:0xf
  v_dot2c_f32_bf16_dpp v26, v12, v57 row_newbcast:0 row_mask:0xf bank_mask:0xf
  v_dot2c_f32_bf16_dpp v27, v13, v57 row_newbcast:0 row_mask:0xf bank_mask:0xf
  v_dot2c_f32_bf16_dpp v28, v12, v58 row_newbcast:0 row_mask:0xf bank_mask:0xf
  v_dot2c_f32_bf16_dpp v29, v13, v58 row_newbcast:0 row_mask:0xf bank_mask:0xf
  v_dot2c_f32_bf16_dpp v30, v12, v59 row_newbcast:0 row_mask:0xf bank_mask:0xf
  v_dot2c_f32_bf16_dpp v31, v13, v59 row_newbcast:0 row_mask:0xf bank_mask:0xf
  v_dot2c_f32_bf16_dpp v24, v12, v60 row_newbcast:1 row_mask:0xf bank_mask:0xf
  v_dot2c_f32_bf16_dpp v25, v13, v60 row_newbcast:1 row_mask:0xf bank_mask:0xf
  v_dot2c_f32_bf16_dpp v26, v12, v61 row_newbcast:1 row_mask:0xf bank_mask:0xf
  v_dot2c_f32_bf16_dpp v27, v13, v61 row_newbcast:1 row_mask:0xf bank_mask:0xf
  v_dot2c_f32_bf16_dpp v28, v12, v62 row_newbcast:1 row_mask:0xf bank_mask:0xf
  v_dot2c_f32_bf16_dpp v29, v13, v62 row_newbcast:1 row_mask:0xf bank_mask:0xf
  v_dot2c_f32_bf16_dpp v30, v12, v63 row_newbcast:1 row_mask:0xf bank_mask:0xf
  v_dot2c_f32_bf16_dpp v31, v13, v63 row_newbcast:1 row_mask:0xf bank_mask:0xf
  v_dot2c_f32_bf16_dpp v24, v12, v64 row_newbcast:4 row_mask:0xf bank_mask:0xf
  v_dot2c_f32_bf16_dpp v25, v13, v64 row_newbcast:4 row_mask:0xf bank_mask:0xf
  v_dot2c_f32_bf16_dpp v26, v12, v65 row_newbcast:4 row_mask:0xf bank_mask:0xf
  v_dot2c_f32_bf16_dpp v27, v13, v65 row_newbcast:4 row_mask:0xf bank_mask:0xf
  v_dot2c_f32_bf16_dpp v28, v12, v66 row_newbcast:4 row_mask:0xf bank_mask:0xf
  v_dot2c_f32_bf16_dpp v29, v13, v66 row_newbcast:4 row_mask:0xf bank_mask:0xf
  v_dot2c_f32_bf16_dpp v30, v12, v67 row_newbcast:4 row_mask:0xf bank_mask:0xf
  v_dot2c_f32_bf16_dpp v31, v13, v67 row_newbcast:4 row_mask:0xf bank_mask:0xf
  v_dot2c_f32_bf16_dpp v24, v12, v68 row_newbcast:5 row_mask:0xf bank_mask:0xf
  v_dot2c_f32_bf16_dpp v25, v13, v68 row_newbcast:5 row_mask:0xf bank_mask:0xf
  v_dot2c_f32_bf16_dpp v26, v12, v69 row_newbcast:5 row_mask:0xf bank_mask:0xf
  v_dot2c_f32_bf16_dpp v27, v13, v69 row_newbcast:5 row_mask:0xf bank_mask:0xf
  v_dot2c_f32_bf16_dpp v28, v12, v70 row_newbcast:5 row_mask:0xf bank_mask:0xf
  v_dot2c_f32_bf16_dpp v29, v13, v70 row_newbcast:5 row_mask:0xf bank_mask:0xf
  v_dot2c_f32_bf16_dpp v30, v12, v71 row_newbcast:5 row_mask:0xf bank_mask:0xf
  v_dot2c_f32_bf16_dpp v31, v13, v71 row_newbcast:5 row_mask:0xf bank_mask:0xf
  s_nop 1
  v_cmp_ne_u32 vcc, v9, v8
  s_cbranch_vccz K2_FL3
  s_mov_b64 exec, vcc
  v_and_b32 v17, 0xffffff00, v8
  v_lshl_add_u32 v17, v17, 1, v2
  ds_write_b128 v17, v[24:27]
  ds_write_b128 v17, v[28:31] offset:256
  v_mov_b32 v24, 0
  v_mov_b32 v25, 0
  v_mov_b32 v26, 0
  v_mov_b32 v27, 0
  v_mov_b32 v28, 0
  v_mov_b32 v29, 0
  v_mov_b32 v30, 0
  v_mov_b32 v31, 0
  s_mov_b64 exec, -1
K2_FL3:
  v_dot2c_f32_bf16_dpp v24, v12, v72 row_newbcast:8 row_mask:0xf bank_mask:0xf
  v_dot2c_f32_bf16_dpp v25, v13, v72 row_newbcast:8 row_mask:0xf bank_mask:0xf
  v_dot2c_f32_bf16_dpp v26, v12, v73 row_newbcast:8 row_mask:0xf bank_mask:0xf
  v_dot2c_f32_bf16_dpp v27, v13, v73 row_newbcast:8 row_mask:0xf bank_mask:0xf
  v_dot2c_f32_bf16_dpp v28, v12, v74 row_newbcast:8 row_mask:0xf bank_mask:0xf
  v_dot2c_f32_bf16_dpp v29, v13, v74 row_newbcast:8 row_mask:0xf bank_mask:0xf
  v_dot2c_f32_bf16_dpp v30, v12, v75 row_newbcast:8 row_mask:0xf bank_mask:0xf
  v_dot2c_f32_bf16_dpp v31, v13, v75 row_newbcast:8 row_mask:0xf bank_mask:0xf
  v_dot2c_f32_bf16_dpp v24, v12, v76 row_newbcast:9 row_mask:0xf bank_mask:0xf
  v_dot2c_f32_bf16_dpp v25, v13, v76 row_newbcast:9 row_mask:0xf bank_mask:0xf
  v_dot2c_f32_bf16_dpp v26, v12, v77 row_newbcast:9 row_mask:0xf bank_mask:0xf
  v_dot2c_f32_bf16_dpp v27, v13, v77 row_newbcast:9 row_mask:0xf bank_mask:0xf
  v_dot2c_f32_bf16_dpp v28, v12, v78 row_newbcast:9 row_mask:0xf bank_mask:0xf
  v_dot2c_f32_bf16_dpp v29, v13, v78 row_newbcast:9 row_mask:0xf bank_mask:0xf
  v_dot2c_f32_bf16_dpp v30, v12, v79 row_newbcast:9 row_mask:0xf bank_mask:0xf
  v_dot2c_f32_bf16_dpp v31, v13, v79 row_newbcast:9 row_mask:0xf bank_mask:0xf
  v_dot2c_f32_bf16_dpp v24, v12, v80 row_newbcast:12 row_mask:0xf bank_mask:0xf
  v_dot2c_f32_bf16_dpp v25, v13, v80 row_newbcast:12 row_mask:0xf bank_mask:0xf
  v_dot2c_f32_bf16_dpp v26, v12, v81 row_newbcast:12 row_mask:0xf bank_mask:0xf
  v_dot2c_f32_bf16_dpp v27, v13, v81 row_newbcast:12 row_mask:0xf bank_mask:0xf
  v_dot2c_f32_bf16_dpp v28, v12, v82 row_newbcast:12 row_mask:0xf bank_mask:0xf
  v_dot2c_f32_bf16_dpp v29, v13, v82 row_newbcast:12 row_mask:0xf bank_mask:0xf
  v_dot2c_f32_bf16_dpp v30, v12, v83 row_newbcast:12 row_mask:0xf bank_mask:0xf
  v_dot2c_f32_bf16_dpp v31, v13, v83 row_newbcast:12 row_mask:0xf bank_mask:0xf
  v_dot2c_f32_bf16_dpp v24, v12, v84 row_newbcast:13 row_mask:0xf bank_mask:0xf
  v_dot2c_f32_bf16_dpp v25, v13, v84 row_newbcast:13 row_mask:0xf bank_mask:0xf
  v_dot2c_f32_bf16_dpp v26, v12, v85 row_newbcast:13 row_mask:0xf bank_mask:0xf
  v_dot2c_f32_bf16_dpp v27, v13, v85 row_newbcast:13 row_mask:0xf bank_mask:0xf
  v_dot2c_f32_bf16_dpp v28, v12, v86 row_newbcast:13 row_mask:0xf bank_mask:0xf
  v_dot2c_f32_bf16_dpp v29, v13, v86 row_newbcast:13 row_mask:0xf bank_mask:0xf
  v_dot2c_f32_bf16_dpp v30, v12, v87 row_newbcast:13 row_mask:0xf bank_mask:0xf
  v_dot2c_f32_bf16_dpp v31, v13, v87 row_newbcast:13 row_mask:0xf bank_mask:0xf
  v_mov_b32 v5, v9
  s_nop 2
  v_and_b32 v17, 0xffffff00, v5
  v_lshl_add_u32 v17, v17, 1, v2
  ds_write_b128 v17, v[24:27]
  ds_write_b128 v17, v[28:31] offset:256
  s_branch K2_MAIN_DONE
K2_NOMAIN:
K2_MAIN_DONE:
  s_setprio 0
  s_cmp_eq_u32 s26, 0
  s_cbranch_scc0 K2_NRDONE
  v_mov_b32 v20, 256
  ds_read_b32 v20, v20
  s_waitcnt lgkmcnt(0)
  v_readfirstlane_b32 s3, v20
  s_nop 3
  s_min_u32 s3, s3, 1564
  s_add_u32 s3, s3, 7
  s_lshr_b32 s3, s3, 3
  s_add_u32 s27, s3, 1
K2_NRDONE:
  s_cmp_eq_u32 s25, 0
  s_cbranch_scc0 K2_NOTBL
  s_add_u32 s3, s53, 1
  s_lshl_b32 s3, s3, 1
  v_cvt_f32_u32 v17, s3
  s_mul_i32 s3, s3, s54
  s_lshl_b32 s32, s3, 2
  s_lshl_b32 s3, s53, 1
  v_cvt_f32_u32 v18, s3
  v_rcp_f32 v17, v17
  v_rcp_f32 v18, v18
  s_lshl_b32 s3, s54, 2
  v_lshrrev_b32 v19, 2, v22
  v_cmp_gt_u32 vcc, s32, v19
  v_cvt_f32_u32 v20, v19
  v_add_f32 v20, 0.5, v20
  v_mul_f32 v20, v20, v17
  v_cvt_u32_f32 v20, v20
  v_subrev_u32 v19, s32, v19
  v_cvt_f32_u32 v19, v19
  v_add_f32 v19, 0.5, v19
  v_mul_f32 v19, v19, v18
  v_cvt_u32_f32 v19, v19
  v_add_u32 v19, s3, v19
  v_cndmask_b32_e64 v40, v19, v20, vcc
  v_add_u32 v19, v22, v23
  v_lshrrev_b32 v19, 2, v19
  v_add_u32 v19, -1, v19
  v_cmp_gt_u32 vcc, s32, v19
  v_cvt_f32_u32 v20, v19
  v_add_f32 v20, 0.5, v20
  v_mul_f32 v20, v20, v17
  v_cvt_u32_f32 v20, v20
  v_subrev_u32 v19, s32, v19
  v_cvt_f32_u32 v19, v19
  v_add_f32 v19, 0.5, v19
  v_mul_f32 v19, v19, v18
  v_cvt_u32_f32 v19, v19
  v_add_u32 v19, s3, v19
  v_cndmask_b32_e64 v41, v19, v20, vcc
  v_sub_u32 v17, v41, v40
  v_add_u32 v17, 1, v17
  v_cmp_lt_u32 vcc, 0, v23
  v_add_u32 v18, v40, v21
  v_lshlrev_b32 v18, 9, v18
  v_cndmask_b32_e64 v17, 0, v17, vcc
  v_add_u32 v18, 62720, v18
  v_lshlrev_b32 v20, 2, v21
  v_mov_b32 v19, 512
  ds_write_b32 v20, v17 offset:2048
  v_cmp_lt_u32 vcc, 0, v17
  v_add_u32 v20, 0, v18
  s_nop 0
  v_cndmask_b32_e64 v44, v19, v20, vcc
  v_cmp_lt_u32 vcc, 1, v17
  v_add_u32 v20, 512, v18
  s_nop 0
  v_cndmask_b32_e64 v45, v19, v20, vcc
  v_cmp_lt_u32 vcc, 2, v17
  v_add_u32 v20, 1024, v18
  s_nop 0
  v_cndmask_b32_e64 v46, v19, v20, vcc
  v_cmp_lt_u32 vcc, 3, v17
  v_add_u32 v20, 1536, v18
  s_nop 0
  v_cndmask_b32_e64 v47, v19, v20, vcc
  v_lshlrev_b32 v17, 4, v21
  ds_write_b128 v17, v[44:47] offset:1024
K2_NOTBL:
  s_cmp_ge_u32 s25, 8
  s_cbranch_scc1 K2_NOAA
  s_and_b32 s32, s25, 3
  s_lshr_b32 s33, s25, 2
  v_bfe_u32 v19, v21, 2, 2
  v_lshrrev_b32 v20, 5, v21
  v_lshl_add_u32 v12, v20, 3, v19
  v_lshlrev_b32 v12, 8, v12
  v_xor_b32 v19, s32, v19
  v_lshl_add_u32 v12, v19, 6, v12
  v_bfe_u32 v19, v21, 4, 1
  v_bfe_u32 v20, v21, 1, 1
  v_lshl_add_u32 v19, v19, 1, v20
  v_and_b32 v20, 1, v21
  v_lshl_add_u32 v19, v20, 2, v19
  v_lshl_add_u32 v12, v19, 3, v12
  v_add_u32 v12, 120576, v12
  ds_read_b64_tr_b16 v[88:89], v12 offset:0
  ds_read_b64_tr_b16 v[90:91], v12 offset:1024
  ds_read_b64_tr_b16 v[92:93], v12 offset:4096
  ds_read_b64_tr_b16 v[94:95], v12 offset:5120
  ds_read_b64_tr_b16 v[96:97], v12 offset:8192
  ds_read_b64_tr_b16 v[98:99], v12 offset:9216
  ds_read_b64_tr_b16 v[100:101], v12 offset:12288
  ds_read_b64_tr_b16 v[102:103], v12 offset:13312
  ds_read_b64_tr_b16 v[104:105], v12 offset:16384
  ds_read_b64_tr_b16 v[106:107], v12 offset:17408
  ds_read_b64_tr_b16 v[108:109], v12 offset:20480
  ds_read_b64_tr_b16 v[110:111], v12 offset:21504
  s_waitcnt lgkmcnt(4)
  ds_read_b64_tr_b16 v[112:113], v12 offset:24576
  ds_read_b64_tr_b16 v[114:115], v12 offset:25600
  ds_read_b64_tr_b16 v[116:117], v12 offset:28672
  ds_read_b64_tr_b16 v[118:119], v12 offset:29696
  v_and_b32 v14, 31, v21
  s_lshl_b32 s3, s33, 5
  v_add_u32 v14, s3, v14
  v_lshrrev_b32 v20, 5, v21
  v_xor_b32 v20, v20, v14
  v_and_b32 v20, 15, v20
  v_lshlrev_b32 v20, 4, v20
  v_lshl_add_u32 v13, v14, 8, v20
  v_xor_b32 v48, 0, v13
  v_xor_b32 v49, 32, v13
  v_xor_b32 v50, 64, v13
  v_xor_b32 v51, 96, v13
  v_xor_b32 v52, 128, v13
  v_xor_b32 v53, 160, v13
  v_xor_b32 v54, 192, v13
  v_xor_b32 v55, 224, v13
  s_mul_i32 s3, s24, 12544
  s_lshl_b32 s52, s32, 6
  s_add_u32 s3, s3, s52
  v_lshrrev_b32 v17, 5, v21
  v_lshlrev_b32 v83, 8, v14
  v_lshl_add_u32 v83, v17, 5, v83
  v_add_u32 v83, s3, v83
K2_NOAA:
  v_lshrrev_b32 v17, 4, v21
  s_lshl_b32 s3, s25, 2
  v_add_u32 v17, s3, v17
  v_lshlrev_b32 v80, 4, v17
  v_lshlrev_b32 v81, 2, v17
  v_xor_b32 v82, v80, v1
  v_and_b32 v82, 0xf0, v82
  v_lshl_add_u32 v82, v17, 8, v82
  s_waitcnt lgkmcnt(0)
  s_barrier
  s_cmp_ge_u32 s25, 13
  s_cbranch_scc1 K2_RED_DONE
  ds_read_b128 v[40:43], v80 offset:1024
  ds_read_b32 v20, v81 offset:2048
  s_waitcnt lgkmcnt(0)
  v_add_u32 v40, v40, v1
  ds_read_b128 v[56:59], v40
  ds_read_b128 v[60:63], v40 offset:256
  v_add_u32 v41, v41, v1
  ds_read_b128 v[64:67], v41
  ds_read_b128 v[68:71], v41 offset:256
  v_add_u32 v42, v42, v1
  ds_read_b128 v[72:75], v42
  ds_read_b128 v[76:79], v42 offset:256
  s_waitcnt lgkmcnt(4)
  v_add_f32 v120, v120, v56
  v_add_f32 v121, v121, v57
  v_add_f32 v122, v122, v58
  v_add_f32 v123, v123, v59
  v_add_f32 v124, v124, v60
  v_add_f32 v125, v125, v61
  v_add_f32 v126, v126, v62
  v_add_f32 v127, v127, v63
  s_waitcnt lgkmcnt(2)
  v_add_f32 v120, v120, v64
  v_add_f32 v121, v121, v65
  v_add_f32 v122, v122, v66
  v_add_f32 v123, v123, v67
  v_add_f32 v124, v124, v68
  v_add_f32 v125, v125, v69
  v_add_f32 v126, v126, v70
  v_add_f32 v127, v127, v71
  s_waitcnt lgkmcnt(0)
  v_add_f32 v120, v120, v72
  v_add_f32 v121, v121, v73
  v_add_f32 v122, v122, v74
  v_add_f32 v123, v123, v75
  v_add_f32 v124, v124, v76
  v_add_f32 v125, v125, v77
  v_add_f32 v126, v126, v78
  v_add_f32 v127, v127, v79
  s_mov_b32 s55, 3
K2_XL:
  v_cmp_lt_u32 vcc, s55, v20
  s_cbranch_vccz K2_RED_DONE
  s_lshl_b32 s3, s55, 9
  v_add_u32 v17, s3, v40
  s_mov_b64 exec, vcc
  ds_read_b128 v[56:59], v17
  ds_read_b128 v[60:63], v17 offset:256
  s_waitcnt lgkmcnt(0)
  v_add_f32 v120, v120, v56
  v_add_f32 v121, v121, v57
  v_add_f32 v122, v122, v58
  v_add_f32 v123, v123, v59
  v_add_f32 v124, v124, v60
  v_add_f32 v125, v125, v61
  v_add_f32 v126, v126, v62
  v_add_f32 v127, v127, v63
  s_mov_b64 exec, -1
  s_add_u32 s55, s55, 1
  s_branch K2_XL
K2_RED_DONE:
  s_add_u32 s26, s26, 1
  s_cmp_ge_u32 s26, s27
  s_cbranch_scc1 K2_EPI
  s_barrier
  s_cmp_ge_u32 s25, 4
  s_cbranch_scc1 K2_RZ
  v_mov_b32 v19, 0
  v_lshlrev_b32 v20, 2, v0
  ds_write_b32 v20, v19 offset:0
K2_RZ:
  v_bfe_u32 v19, v21, 2, 1
  v_mul_u32_u24 v19, 12, v19
  v_and_b32 v20, 3, v21
  v_or_b32 v19, v19, v20
  v_lshlrev_b32 v4, 8, v21
  v_lshl_or_b32 v4, v19, 4, v4
  s_waitcnt lgkmcnt(0)
  s_barrier
  s_cmp_lt_u32 s25, 8
  s_cbranch_scc1 K2_HDRD
  v_mov_b32 v56, 63
  v_mov_b32 v57, 63
  v_mov_b32 v58, 63
  v_mov_b32 v59, 63
  v_mov_b32 v60, 63
  v_mov_b32 v61, 63
  v_mov_b32 v62, 63
  v_mov_b32 v63, 63
  v_subrev_u32 v17, 512, v0
  v_and_b32 v18, 1, v17
  v_lshrrev_b32 v17, 1, v17
  v_lshlrev_b32 v19, 2, v17
  v_add_u32 v19, 155904, v19
  ds_read_b32 v20, v19
  v_lshlrev_b32 v17, 14, v17
  v_add_u32 v17, 5242880, v17
  s_lshl_b32 s3, s26, 3
  s_sub_u32 s3, s3, 8
  v_lshl_add_u32 v18, v18, 2, s3
  v_lshl_add_u32 v17, v18, 3, v17
  s_mov_b32 s53, 8388608
  s_mov_b32 s55, 131072
  s_waitcnt lgkmcnt(0)
  v_sub_u32 v20, v20, v18
  v_cmp_lt_i32 vcc, 0, v20
  s_and_saveexec_b64 s[50:51], vcc
  s_cbranch_execz K2_R1
  v_cmp_lt_i32 s[36:37], 1, v20
  v_cmp_lt_i32 s[38:39], 2, v20
  v_cmp_lt_i32 s[40:41], 3, v20
K2_RP:
  buffer_load_dwordx4 v[68:71], v17, s[20:23], 0 offen sc1
  buffer_load_dwordx4 v[72:75], v17, s[20:23], 0 offen offset:16 sc1
  s_waitcnt vmcnt(0)
  v_xor_b32 v68, s30, v68
  v_xor_b32 v69, s30, v69
  v_xor_b32 v70, s30, v70
  v_xor_b32 v71, s30, v71
  v_xor_b32 v72, s30, v72
  v_xor_b32 v73, s30, v73
  v_xor_b32 v74, s30, v74
  v_xor_b32 v75, s30, v75
  v_or_b32 v18, v68, v69
  v_or_b32 v19, v70, v71
  v_cndmask_b32_e64 v19, 0, v19, s[36:37]
  v_or_b32 v18, v18, v19
  v_or_b32 v19, v72, v73
  v_cndmask_b32_e64 v19, 0, v19, s[38:39]
  v_or_b32 v18, v18, v19
  v_or_b32 v19, v74, v75
  v_cndmask_b32_e64 v19, 0, v19, s[40:41]
  v_or_b32 v18, v18, v19
  v_cmp_le_u32 vcc, s53, v18
  s_cbranch_vccz K2_RPD
  s_sleep 2
  s_sub_u32 s55, s55, 1
  s_cmp_lg_u32 s55, 0
  s_cbranch_scc1 K2_RP
K2_RPD:
  v_cmp_eq_u32 vcc, s24, v69
  s_nop 1
  v_cndmask_b32_e64 v56, v56, v68, vcc
  v_cmp_eq_u32 vcc, s24, v71
  s_nop 0
  s_and_b64 vcc, vcc, s[36:37]
  s_nop 1
  v_cndmask_b32_e64 v57, v57, v70, vcc
  v_cmp_eq_u32 vcc, s24, v73
  s_nop 0
  s_and_b64 vcc, vcc, s[38:39]
  s_nop 1
  v_cndmask_b32_e64 v58, v58, v72, vcc
  v_cmp_eq_u32 vcc, s24, v75
  s_nop 0
  s_and_b64 vcc, vcc, s[40:41]
  s_nop 1
  v_cndmask_b32_e64 v59, v59, v74, vcc
K2_R1:
  s_mov_b64 exec, s[50:51]
  v_mov_b32 v20, 1
  s_branch K2_DECODE
K2_EPI:
  s_cmp_ge_u32 s25, 13
  s_cbranch_scc1 K2_WB_DONE
  v_cvt_pk_bf16_f32 v40, v120, v121
  v_cvt_pk_bf16_f32 v41, v122, v123
  v_cvt_pk_bf16_f32 v42, v124, v125
  v_cvt_pk_bf16_f32 v43, v126, v127
  ds_write_b128 v82, v[40:43] offset:46336
K2_WB_DONE:
  s_waitcnt lgkmcnt(0)
  s_barrier
  s_cmp_ge_u32 s25, 8
  s_cbranch_scc1 K2_FIN
  v_mov_b32 v40, v83
  ds_read_b128 v[56:59], v48 offset:46336
  ds_read_b128 v[60:63], v49 offset:46336
  ds_read_b128 v[64:67], v50 offset:46336
  ds_read_b128 v[68:71], v51 offset:46336
  ds_read_b128 v[72:75], v52 offset:46336
  ds_read_b128 v[76:79], v53 offset:46336
  ds_read_b128 v[80:83], v54 offset:46336
  ds_read_b128 v[84:87], v55 offset:46336
  v_cmp_gt_u32 vcc, 49, v14
  s_waitcnt lgkmcnt(7)
  v_mfma_f32_32x32x16_bf16 v[24:39], v[88:91], v[56:59], 0
  s_waitcnt lgkmcnt(6)
  v_mfma_f32_32x32x16_bf16 v[24:39], v[92:95], v[60:63], v[24:39]
  s_waitcnt lgkmcnt(5)
  v_mfma_f32_32x32x16_bf16 v[24:39], v[96:99], v[64:67], v[24:39]
  s_waitcnt lgkmcnt(4)
  v_mfma_f32_32x32x16_bf16 v[24:39], v[100:103], v[68:71], v[24:39]
  s_waitcnt lgkmcnt(3)
  v_mfma_f32_32x32x16_bf16 v[24:39], v[104:107], v[72:75], v[24:39]
  s_waitcnt lgkmcnt(2)
  v_mfma_f32_32x32x16_bf16 v[24:39], v[108:111], v[76:79], v[24:39]
  s_waitcnt lgkmcnt(1)
  v_mfma_f32_32x32x16_bf16 v[24:39], v[112:115], v[80:83], v[24:39]
  s_waitcnt lgkmcnt(0)
  v_mfma_f32_32x32x16_bf16 v[24:39], v[116:119], v[84:87], v[24:39]
  s_nop 7
  s_nop 3
  v_cvt_pk_bf16_f32 v48, v24, v25
  v_cvt_pk_bf16_f32 v49, v26, v27
  v_cvt_pk_bf16_f32 v50, v28, v29
  v_cvt_pk_bf16_f32 v51, v30, v31
  v_cvt_pk_bf16_f32 v52, v32, v33
  v_cvt_pk_bf16_f32 v53, v34, v35
  v_cvt_pk_bf16_f32 v54, v36, v37
  v_cvt_pk_bf16_f32 v55, v38, v39
  s_and_saveexec_b64 s[50:51], vcc
  s_cbranch_execz K2_ST_DONE
  buffer_store_dwordx4 v[48:51], v40, s[16:19], 0 offen
  buffer_store_dwordx4 v[52:55], v40, s[16:19], 0 offen offset:16
K2_ST_DONE:
  s_mov_b64 exec, s[50:51]
K2_FIN:
  s_cmp_eq_u32 s2, 0
  s_cbranch_scc0 K2_NOEPOCH
  s_cmp_eq_u32 s25, 15
  s_cbranch_scc0 K2_NOEPOCH
  v_mov_b32 v17, 0
  v_mov_b32 v18, s30
  s_mov_b64 exec, 1
  buffer_store_dword v18, v17, s[20:23], 0 offen sc1
  s_mov_b64 exec, -1
K2_NOEPOCH:
K2_END:
  s_endpgm
.section .rodata,"a"
.p2align 6
.amdhsa_kernel gather_scatter__kernel_systems_refs_featgraph__graph_kernel
  .amdhsa_next_free_vgpr 128
  .amdhsa_next_free_sgpr 102
  .amdhsa_accum_offset 128
  .amdhsa_group_segment_fixed_size 0
  .amdhsa_kernarg_size 64
  .amdhsa_user_sgpr_count 2
  .amdhsa_user_sgpr_kernarg_segment_ptr 1
  .amdhsa_system_sgpr_workgroup_id_x 1
.end_amdhsa_kernel
```
